```python
import torch

def _softmax(x, axis=-1):
    return torch.softmax(x, dim=axis)
def _gelu(x):
    return torch.nn.functional.gelu(x, approximate="tanh")
def _silu(x):
    return torch.nn.functional.silu(x)
def _sigmoid(x):
    return torch.sigmoid(x)
def _layernorm(x, axis=-1, eps=1e-5):
    m = x.mean(dim=axis, keepdim=True)
    v = x.var(dim=axis, keepdim=True, unbiased=False)
    return (x - m) / torch.sqrt(v + eps)
def _scatter_add(tgt, idx, src, axis=0):
    return tgt.clone().index_add_(axis, idx, src)
def _segment_sum(src, seg, n):
    out = torch.zeros((n,) + src.shape[1:], dtype=src.dtype)
    return out.index_add_(0, seg, src)
def _pad(x, pw):
    flat = tuple(v for pair in reversed(pw) for v in pair)
    return torch.nn.functional.pad(x, flat)

kernel_name = 'recurrent_scan__sliding_block_cached__glu_gated_glu__decode'

def setup_inputs():

    _w = (lambda a: (lambda t: t.to(torch.bfloat16) if t.is_floating_point() else t)(torch.as_tensor(a)))
    def _A_setup():
        B, Sq, D = 1, 1, 1024
        Hq, Hkv, Sk, Dh = 32, 4, 65536, 128
        assert Hq % Hkv == 0, (Hq, Hkv)
        return {
            "x": _w((lambda *s: torch.randn(*s, dtype=torch.bfloat16) * 0.05)(B, Sq, D)),
            "k_cache": _w((lambda *s: torch.randn(*s, dtype=torch.bfloat16) * 1.6)(B, Hkv, Sk, Dh)),
            "v_cache": _w((lambda *s: torch.randn(*s, dtype=torch.bfloat16) * 0.2)(B, Hkv, Sk, Dh)),
            "wq": _w((lambda *s: torch.randn(*s, dtype=torch.bfloat16) * 1.6)(D, Hq * Dh) * (D ** -0.5)),
            "wo": _w((lambda *s: torch.randn(*s, dtype=torch.bfloat16) * 0.2)(Hq * Dh, D) * ((Hq * Dh) ** -0.5)),
        }
    _A_in = _A_setup()

    def _B_setup():
        B, S, D, F = 1, 1, 1024, 3584
        return {
            "x": _w((lambda *s: torch.randn(*s, dtype=torch.bfloat16) * 0.05)(B, S, D)),
            "w_gate": _w((lambda *s: torch.randn(*s, dtype=torch.bfloat16) * 0.2)(D, F)),
            "w_up": _w((lambda *s: torch.randn(*s, dtype=torch.bfloat16) * 0.1)(D, F)),
            "w_down": _w((lambda *s: torch.randn(*s, dtype=torch.bfloat16) * 0.1)(F, D)),
        }
    _B_in = _B_setup()

    return {
        "A_x": _A_in["x"],
        "A_k_cache": _A_in["k_cache"],
        "A_v_cache": _A_in["v_cache"],
        "A_wq": _A_in["wq"],
        "A_wo": _A_in["wo"],
        "B_x": _B_in["x"],
        "B_w_gate": _B_in["w_gate"],
        "B_w_up": _B_in["w_up"],
        "B_w_down": _B_in["w_down"],
    }

def reference(A_x, A_k_cache, A_v_cache, A_wq, A_wo, B_x, B_w_gate, B_w_up, B_w_down):
    def _A_ref(x, k_cache, v_cache, wq, wo):
        B, Sq, D = x.shape
        Hq, Dh = 32, 128
        Hkv, Sk = k_cache.shape[1], k_cache.shape[2]
        W = min(4096, max(256, Sk // 4))
        rep = Hq // Hkv
        q = (lambda x, *d: x.permute(*d))((x @ wq).reshape(B, Sq, Hq, Dh), 0, 2, 1, 3)
        k = (lambda x, n, axis: torch.repeat_interleave(x, n, dim=axis))(k_cache[:, :, Sk - W:, :], rep, axis=1)
        v = (lambda x, n, axis: torch.repeat_interleave(x, n, dim=axis))(v_cache[:, :, Sk - W:, :], rep, axis=1)
        scores = torch.einsum("bhqd,bhkd->bhqk", q, k) * (Dh ** -0.5)
        p = _softmax(scores, axis=-1)
        o = torch.einsum("bhqk,bhkd->bhqd", p, v)
        return (lambda x, *d: x.permute(*d))(o, 0, 2, 1, 3).reshape(B, Sq, Hq * Dh) @ wo

    def _B_ref(x, w_gate, w_up, w_down):
        g = torch.einsum("bsd,df->bsf", x, w_gate)
        u = torch.einsum("bsd,df->bsf", x, w_up)
        h = _sigmoid(g) * u
        return torch.einsum("bsf,fd->bsd", h, w_down)

    x = A_x
    xn = _layernorm(x, axis=-1)
    s = _A_ref(xn, A_k_cache, A_v_cache, A_wq, A_wo)
    g = _silu(_B_ref(xn, B_w_gate, B_w_up, B_w_down))
    return x + s * g
```

```asm
; @launch grid=(240,1,1) block=(512,1,1) lds=79872
.amdgcn_target "amdgcn-amd-amdhsa--gfx950"
.text
.globl recurrent_scan__sliding_block_cached__glu_gated_glu__decode_kernel
.p2align 8
.type recurrent_scan__sliding_block_cached__glu_gated_glu__decode_kernel,@function
recurrent_scan__sliding_block_cached__glu_gated_glu__decode_kernel:
  s_cmp_ge_u32 s2, 240
  s_cbranch_scc1 L_end
  s_load_dwordx16 s[16:31], s[0:1], 0
  s_load_dwordx8 s[32:39], s[0:1], 64
  v_lshrrev_b32 v1, 6, v0
  v_and_b32 v0, 63, v0
  v_readfirstlane_b32 s4, v1
  s_mov_b32 s43, 0x20000
  v_lshrrev_b32 v2, 4, v0
  v_and_b32 v3, 15, v0
  s_cmp_lt_u32 s4, 4
  s_cbranch_scc1 L_X
  s_setprio 3
  v_lshlrev_b32 v1, 5, v0
  s_lshl_b32 s9, s4, 9
  s_sub_u32 s9, s9, 2048
  v_lshlrev_b32 v9, 3, v0
  s_mov_b32 s42, 2048
  s_waitcnt lgkmcnt(0)
  s_mov_b32 s40, s16
  s_mov_b32 s41, s17
  buffer_load_dwordx4 v[112:115], v1, s[40:43], 0 offen
  buffer_load_dwordx4 v[116:119], v1, s[40:43], 0 offen offset:16
  buffer_load_dwordx2 v[110:111], v9, s[40:43], s9 offen
  s_mov_b32 s36, s38
  s_mov_b32 s37, s39
  s_mov_b32 s38, 0x168000
  s_mov_b32 s39, 0x20000
  buffer_load_dword v124, off, s[36:39], 0 offset:0 sc1
  s_branch L_Y
L_X:
  s_cmp_ge_u32 s2, 128
  s_cbranch_scc1 L_BX
  s_and_b32 s5, s2, 7
  s_lshl_b32 s5, s5, 4
  s_lshr_b32 s6, s2, 3
  s_add_u32 s5, s5, s6
  s_add_u32 s59, s5, 32
  s_and_b32 s59, s59, 127
  v_lshlrev_b32 v1, 17, v2
  v_lshl_add_u32 v1, v3, 4, v1
  s_and_b32 s6, s59, 7
  s_lshl_b32 s6, s6, 1
  s_lshr_b32 s7, s4, 1
  s_add_u32 s6, s6, s7
  s_lshr_b32 s57, s59, 3
  s_lshl_b32 s57, s57, 1
  s_and_b32 s7, s4, 1
  s_add_u32 s57, s57, s7
  s_lshl_b32 s8, s6, 19
  s_lshl_b32 s7, s57, 8
  s_add_u32 s8, s8, s7
  s_lshl_b32 s9, s6, 8
  s_mov_b32 s42, 0x800000
  s_waitcnt lgkmcnt(0)
  s_mov_b32 s40, s22
  s_mov_b32 s41, s23
  buffer_load_dwordx4 v[56:59], v1, s[40:43], s8 offen nt
  s_add_u32 s8, s8, 65536
  buffer_load_dwordx4 v[60:63], v1, s[40:43], s8 offen nt
  s_sub_u32 s8, s8, 57344
  buffer_load_dwordx4 v[64:67], v1, s[40:43], s8 offen nt
  s_add_u32 s8, s8, 65536
  buffer_load_dwordx4 v[68:71], v1, s[40:43], s8 offen nt
  s_sub_u32 s8, s8, 57344
  buffer_load_dwordx4 v[72:75], v1, s[40:43], s8 offen nt
  s_add_u32 s8, s8, 65536
  buffer_load_dwordx4 v[76:79], v1, s[40:43], s8 offen nt
  s_sub_u32 s8, s8, 57344
  buffer_load_dwordx4 v[80:83], v1, s[40:43], s8 offen nt
  s_add_u32 s8, s8, 65536
  buffer_load_dwordx4 v[84:87], v1, s[40:43], s8 offen nt
  s_sub_u32 s8, s8, 57344
  buffer_load_dwordx4 v[88:91], v1, s[40:43], s8 offen nt
  s_add_u32 s8, s8, 65536
  s_branch L_AX2
L_BX:
  s_sub_u32 s6, s2, 128
  s_and_b32 s5, s6, 7
  s_mul_i32 s5, s5, 14
  s_lshr_b32 s6, s6, 3
  s_add_u32 s5, s5, s6
  s_mov_b32 s6, 229376
  v_mul_lo_u32 v1, v2, s6
  v_lshl_add_u32 v1, v3, 4, v1
  s_bfe_u32 s9, s5, 0x30001
  s_mul_i32 s8, s9, 917504
  s_lshr_b32 s7, s5, 4
  s_lshl_b32 s7, s7, 2
  s_add_u32 s7, s7, s4
  s_lshl_b32 s56, s7, 9
  s_lshl_b32 s7, s7, 8
  s_add_u32 s8, s8, s7
  s_mov_b32 s42, 7340032
  s_and_b32 s6, s5, 1
  s_cmp_eq_u32 s6, 0
  s_waitcnt lgkmcnt(0)
  s_cselect_b32 s40, s28, s30
  s_cselect_b32 s41, s29, s31
  buffer_load_dwordx4 v[56:59], v1, s[40:43], s8 offen nt
  s_add_u32 s8, s8, 114688
  buffer_load_dwordx4 v[60:63], v1, s[40:43], s8 offen nt
  s_sub_u32 s8, s8, 107520
  buffer_load_dwordx4 v[64:67], v1, s[40:43], s8 offen nt
  s_add_u32 s8, s8, 114688
  buffer_load_dwordx4 v[68:71], v1, s[40:43], s8 offen nt
  s_sub_u32 s8, s8, 107520
  buffer_load_dwordx4 v[72:75], v1, s[40:43], s8 offen nt
  s_add_u32 s8, s8, 114688
  s_branch L_BX2
L_AX2:
  s_mov_b32 s36, s38
  s_mov_b32 s37, s39
  s_mov_b32 s38, 0x168000
  s_mov_b32 s39, 0x20000
  buffer_load_dword v124, off, s[36:39], 0 offset:0 sc1
  s_setprio 3
  v_lshrrev_b32 v9, 3, v0
  v_lshl_add_u32 v120, v9, 5, s9
  v_and_b32 v9, 1, v0
  v_lshlrev_b32 v9, 4, v9
  v_mov_b32 v10, 0xffff
  v_lshlrev_b32 v10, v9, v10
  v_bfe_u32 v9, v0, 1, 2
  v_cmp_eq_u32 vcc, 0, v9
  s_nop 1
  v_cndmask_b32 v4, 0, v10, vcc
  v_cmp_eq_u32 vcc, 1, v9
  s_nop 1
  v_cndmask_b32 v5, 0, v10, vcc
  v_cmp_eq_u32 vcc, 2, v9
  s_nop 1
  v_cndmask_b32 v6, 0, v10, vcc
  v_cmp_eq_u32 vcc, 3, v9
  s_nop 1
  v_cndmask_b32 v7, 0, v10, vcc
  s_mov_b32 s44, s18
  s_mov_b32 s45, s19
  s_mov_b32 s46, 0x4000000
  s_mov_b32 s47, 0x20000
  s_mov_b32 s60, s20
  s_mov_b32 s61, s21
  s_mov_b32 s62, 0x4000000
  s_mov_b32 s63, 0x20000
  s_lshr_b32 s56, s5, 5
  s_mul_i32 s50, s56, 12288
  s_and_b32 s50, s50, 0x7000
  s_lshl_b32 s56, s56, 24
  s_and_b32 s7, s5, 31
  s_lshl_b32 s7, s7, 15
  s_add_u32 s56, s56, s7
  s_lshl_b32 s7, s4, 10
  s_add_u32 s56, s56, s7
  s_add_u32 s56, s56, 15728640
  s_add_u32 s58, s7, 12288
  s_add_u32 s51, s7, 45056
  s_lshl_b32 s7, s4, 2
  v_add_u32 v9, s7, v2
  v_xor_b32 v10, v9, v3
  v_lshlrev_b32 v10, 4, v10
  v_lshl_add_u32 v121, v2, 8, v10
  v_and_b32 v9, 7, v9
  v_lshlrev_b32 v10, 1, v9
  v_xor_b32 v10, v10, v3
  v_lshlrev_b32 v10, 4, v10
  v_lshl_add_u32 v122, v2, 8, v10
  s_lshr_b32 s6, s57, 3
  s_lshl_b32 s6, s6, 15
  s_and_b32 s57, s57, 7
  s_lshl_b32 s57, s57, 9
  s_add_u32 s57, s57, s6
  s_and_b32 s6, s59, 7
  s_lshl_b32 s6, s6, 12
  s_add_u32 s57, s57, s6
  s_add_u32 s57, s57, 4096
  v_lshlrev_b32 v125, 4, v0
  s_lshl_b32 s6, s4, 9
  v_add_u32 v126, s6, v125
  v_xor_b32 v127, 0x400, v126
  s_waitcnt vmcnt(8)
  buffer_load_dwordx4 v[92:95], v1, s[40:43], s8 offen nt
  s_sub_u32 s8, s8, 57344
  s_waitcnt vmcnt(8)
  buffer_load_dwordx4 v[96:99], v1, s[40:43], s8 offen nt
  s_add_u32 s8, s8, 65536
  s_waitcnt vmcnt(8)
  buffer_load_dwordx4 v[100:103], v1, s[40:43], s8 offen nt
  s_sub_u32 s8, s8, 57344
  s_waitcnt vmcnt(8)
  buffer_load_dwordx4 v[104:107], v1, s[40:43], s8 offen nt
  s_add_u32 s8, s8, 65536
  s_waitcnt vmcnt(8)
  buffer_load_dwordx4 v[108:111], v1, s[40:43], s8 offen nt
  s_sub_u32 s8, s8, 57344
  s_waitcnt vmcnt(8)
  buffer_load_dwordx4 v[112:115], v1, s[40:43], s8 offen nt
  s_add_u32 s8, s8, 65536
  s_barrier
  ds_read_b128 v[24:27], v120 offset:8192
  ds_read_b128 v[28:31], v120 offset:8208
  s_waitcnt lgkmcnt(1)
  v_and_b32 v12, v24, v4
  v_and_b32 v13, v24, v5
  v_and_b32 v14, v24, v6
  v_and_b32 v15, v24, v7
  v_and_b32 v16, v25, v4
  v_and_b32 v17, v25, v5
  s_waitcnt vmcnt(15)
  v_mfma_f32_16x16x32_bf16 v[20:23], v[12:15], v[56:59], 0
  v_and_b32 v18, v25, v6
  v_and_b32 v19, v25, v7
  s_waitcnt vmcnt(14)
  v_mfma_f32_16x16x32_bf16 v[48:51], v[12:15], v[60:63], 0
  v_and_b32 v12, v26, v4
  v_and_b32 v13, v26, v5
  s_waitcnt vmcnt(13)
  v_mfma_f32_16x16x32_bf16 v[20:23], v[16:19], v[64:67], v[20:23]
  v_and_b32 v14, v26, v6
  v_and_b32 v15, v26, v7
  s_waitcnt vmcnt(12)
  v_mfma_f32_16x16x32_bf16 v[48:51], v[16:19], v[68:71], v[48:51]
  s_waitcnt lgkmcnt(0)
  v_and_b32 v16, v27, v4
  v_and_b32 v17, v27, v5
  s_waitcnt vmcnt(11)
  v_mfma_f32_16x16x32_bf16 v[20:23], v[12:15], v[72:75], v[20:23]
  v_and_b32 v18, v27, v6
  v_and_b32 v19, v27, v7
  s_waitcnt vmcnt(10)
  v_mfma_f32_16x16x32_bf16 v[48:51], v[12:15], v[76:79], v[48:51]
  v_and_b32 v12, v28, v4
  v_and_b32 v13, v28, v5
  s_waitcnt vmcnt(9)
  buffer_load_dwordx4 v[116:119], v1, s[40:43], s8 offen nt
  v_mfma_f32_16x16x32_bf16 v[20:23], v[16:19], v[80:83], v[20:23]
  v_and_b32 v14, v28, v6
  v_and_b32 v15, v28, v7
  s_waitcnt vmcnt(9)
  v_mfma_f32_16x16x32_bf16 v[48:51], v[16:19], v[84:87], v[48:51]
  v_and_b32 v16, v29, v4
  v_and_b32 v17, v29, v5
  s_waitcnt vmcnt(8)
  v_mfma_f32_16x16x32_bf16 v[20:23], v[12:15], v[88:91], v[20:23]
  v_and_b32 v18, v29, v6
  v_and_b32 v19, v29, v7
  s_waitcnt vmcnt(6)
  v_mfma_f32_16x16x32_bf16 v[48:51], v[12:15], v[92:95], v[48:51]
  v_and_b32 v12, v30, v4
  v_and_b32 v13, v30, v5
  s_waitcnt vmcnt(5)
  s_add_u32 m0, s50, s58
  s_add_u32 s49, s50, s56
  buffer_load_dwordx4 v121, s[44:47], s49 offen nt lds
  s_add_u32 s50, s50, 4096
  s_and_b32 s50, s50, 0x7000
  v_mfma_f32_16x16x32_bf16 v[20:23], v[16:19], v[96:99], v[20:23]
  v_and_b32 v14, v30, v6
  v_and_b32 v15, v30, v7
  s_waitcnt vmcnt(5)
  s_add_u32 m0, s50, s58
  s_add_u32 s49, s50, s56
  buffer_load_dwordx4 v121, s[44:47], s49 offen nt lds
  s_add_u32 s50, s50, 4096
  s_and_b32 s50, s50, 0x7000
  v_mfma_f32_16x16x32_bf16 v[48:51], v[16:19], v[100:103], v[48:51]
  v_and_b32 v16, v31, v4
  v_and_b32 v17, v31, v5
  s_waitcnt vmcnt(5)
  s_add_u32 m0, s50, s58
  s_add_u32 s49, s50, s56
  buffer_load_dwordx4 v121, s[44:47], s49 offen nt lds
  s_add_u32 s50, s50, 4096
  s_and_b32 s50, s50, 0x7000
  v_mfma_f32_16x16x32_bf16 v[20:23], v[12:15], v[104:107], v[20:23]
  v_and_b32 v18, v31, v6
  v_and_b32 v19, v31, v7
  s_waitcnt vmcnt(5)
  s_add_u32 m0, s50, s58
  s_add_u32 s49, s50, s56
  buffer_load_dwordx4 v121, s[44:47], s49 offen nt lds
  s_add_u32 s50, s50, 4096
  s_and_b32 s50, s50, 0x7000
  v_mfma_f32_16x16x32_bf16 v[48:51], v[12:15], v[108:111], v[48:51]
  s_waitcnt vmcnt(5)
  s_add_u32 m0, s50, s58
  s_add_u32 s49, s50, s56
  buffer_load_dwordx4 v121, s[44:47], s49 offen nt lds
  s_add_u32 s50, s50, 4096
  s_and_b32 s50, s50, 0x7000
  v_mfma_f32_16x16x32_bf16 v[20:23], v[16:19], v[112:115], v[20:23]
  v_readfirstlane_b32 s10, v124
  s_nop 0
  s_add_u32 s10, s10, 0x9e3779b9
  s_bfe_u32 s11, s10, 0x40000
  s_bfe_u32 s12, s10, 0x40004
  s_bfe_u32 s13, s10, 0x40008
  s_bfe_u32 s14, s10, 0x4000c
  s_waitcnt vmcnt(5)
  s_add_u32 m0, s50, s58
  s_add_u32 s49, s50, s56
  buffer_load_dwordx4 v121, s[44:47], s49 offen nt lds
  s_add_u32 s50, s50, 4096
  s_and_b32 s50, s50, 0x7000
  v_mfma_f32_16x16x32_bf16 v[48:51], v[16:19], v[116:119], v[48:51]
  s_and_b32 s6, s4, 1
  s_lshl_b32 s6, s6, 2
  v_mov_b32 v9, s6
  v_mov_b32 v10, 1
  s_nop 3
  v_permlane32_swap_b32 v48, v24
  v_permlane32_swap_b32 v49, v25
  v_permlane32_swap_b32 v50, v26
  v_permlane32_swap_b32 v51, v27
  s_mov_b32 exec_hi, 0
  v_pk_add_f32 v[20:21], v[20:21], v[24:25]
  v_pk_add_f32 v[22:23], v[22:23], v[26:27]
  ds_write_b128 v126, v[20:23] offset:2048
  s_mov_b32 exec_lo, 1
  ds_add_rtn_u32 v10, v9, v10 offset:0
  s_mov_b32 exec_lo, -1
  ds_read_b128 v[24:27], v127 offset:2048
  s_waitcnt lgkmcnt(1)
  v_readfirstlane_b32 s6, v10
  s_cmp_eq_u32 s6, 0
  s_cbranch_scc1 Lnl_1
  s_waitcnt lgkmcnt(0)
  v_pk_add_f32 v[20:21], v[20:21], v[24:25]
  v_pk_add_f32 v[22:23], v[22:23], v[26:27]
  v_add_u32 v20, 8, v20
  v_add_u32 v21, 8, v21
  v_add_u32 v22, 8, v22
  v_add_u32 v23, 8, v23
  v_bfi_b32 v20, 15, s11, v20
  v_bfi_b32 v21, 15, s12, v21
  v_bfi_b32 v22, 15, s13, v22
  v_bfi_b32 v23, 15, s14, v23
  buffer_store_dwordx4 v[20:23], v125, s[36:39], s57 offen sc1
Lnl_1:
  s_mov_b64 exec, -1
  s_waitcnt vmcnt(5)
  s_add_u32 m0, s50, s58
  s_add_u32 s49, s50, s56
  buffer_load_dwordx4 v121, s[44:47], s49 offen nt lds
  s_add_u32 s50, s50, 4096
  s_and_b32 s50, s50, 0x7000
  s_waitcnt vmcnt(5)
  s_add_u32 m0, s50, s58
  s_add_u32 s49, s50, s56
  buffer_load_dwordx4 v121, s[44:47], s49 offen nt lds
  s_add_u32 s50, s50, 4096
  s_and_b32 s50, s50, 0x7000
  s_waitcnt vmcnt(5)
  s_add_u32 m0, s50, s51
  s_add_u32 s49, s50, s56
  buffer_load_dwordx4 v122, s[60:63], s49 offen nt lds
  s_add_u32 s50, s50, 4096
  s_and_b32 s50, s50, 0x7000
  s_waitcnt vmcnt(5)
  s_add_u32 m0, s50, s51
  s_add_u32 s49, s50, s56
  buffer_load_dwordx4 v122, s[60:63], s49 offen nt lds
  s_add_u32 s50, s50, 4096
  s_and_b32 s50, s50, 0x7000
  s_waitcnt vmcnt(5)
  s_add_u32 m0, s50, s51
  s_add_u32 s49, s50, s56
  buffer_load_dwordx4 v122, s[60:63], s49 offen nt lds
  s_add_u32 s50, s50, 4096
  s_and_b32 s50, s50, 0x7000
  s_waitcnt vmcnt(5)
  s_add_u32 m0, s50, s51
  s_add_u32 s49, s50, s56
  buffer_load_dwordx4 v122, s[60:63], s49 offen nt lds
  s_add_u32 s50, s50, 4096
  s_and_b32 s50, s50, 0x7000
  v_mov_b32 v121, v122
  s_mov_b32 s52, s56
  v_lshrrev_b32 v2, 4, v0
  v_and_b32 v3, 15, v0
  v_xor_b32 v10, v2, v3
  v_lshlrev_b32 v10, 4, v10
  v_lshl_add_u32 v1, v3, 8, v10
  s_lshl_b32 s6, s4, 12
  v_xor_b32 v10, 0, v1
  v_add_u32 v43, s6, v10
  v_xor_b32 v10, 64, v1
  v_add_u32 v47, s6, v10
  v_xor_b32 v10, 128, v1
  v_add_u32 v51, s6, v10
  v_xor_b32 v10, 192, v1
  v_add_u32 v55, s6, v10
  v_lshrrev_b32 v1, 2, v0
  v_and_b32 v9, 7, v1
  v_xor_b32 v9, s4, v9
  v_lshlrev_b32 v9, 5, v9
  v_and_b32 v10, 3, v0
  v_lshl_add_u32 v9, v10, 3, v9
  v_lshl_add_u32 v9, v1, 8, v9
  v_add_u32 v122, 45056, v9
  v_and_b32 v1, 7, v0
  v_mul_u32_u24 v123, 272, v1
  v_lshl_add_u32 v123, v2, 4, v123
  v_lshlrev_b32 v124, 2, v3
  s_lshr_b32 s6, s4, 1
  s_lshl_b32 s6, s6, 10
  s_and_b32 s7, s4, 1
  s_lshl_b32 s7, s7, 3
  s_add_u32 s6, s6, s7
  v_lshlrev_b32 v125, 4, v0
  v_add_u32 v126, s6, v125
  v_lshlrev_b32 v127, 4, v3
  v_lshl_add_u32 v127, v2, 7, v127
  s_mul_i32 s58, s5, 4224
  s_lshl_b32 s7, s4, 9
  s_add_u32 s58, s58, s7
  s_add_u32 s58, s58, 393216
  v_mov_b32 v12, 0x3f803f80
  v_mov_b32 v13, v12
  v_mov_b32 v14, v12
  v_mov_b32 v15, v12
  s_lshr_b32 s9, s5, 5
  s_lshl_b32 s9, s9, 15
  s_add_u32 s9, s9, s7
  s_add_u32 s9, s9, 4096
  s_add_u32 s56, s9, 8192
  v_lshrrev_b32 v9, 5, v0
  v_and_b32 v10, 31, v0
  v_lshlrev_b32 v16, 12, v9
  v_lshl_add_u32 v16, v10, 4, v16
  v_add_u32 v17, 16384, v16
  s_mul_i32 s6, s4, 272
  v_lshlrev_b32 v18, 4, v3
  v_lshl_add_u32 v18, v9, 2, v18
  v_and_b32 v10, 1, v2
  v_lshl_add_u32 v18, v10, 3, v18
  v_add_u32 v18, s6, v18
  s_waitcnt vmcnt(5) lgkmcnt(0)
L_att:
  s_barrier
  buffer_load_dwordx4 v[24:27], v16, s[36:39], s9 offen sc1
  buffer_load_dwordx4 v[28:31], v16, s[36:39], s56 offen sc1
  buffer_load_dwordx4 v[32:35], v17, s[36:39], s9 offen sc1
  buffer_load_dwordx4 v[36:39], v17, s[36:39], s56 offen sc1
  s_barrier
  s_cmp_lt_u32 s4, 4
  s_cbranch_scc1 Lxp_5
  s_waitcnt vmcnt(0)
  s_branch Lxq_6
Lxp_5:
  s_add_u32 m0, s50, s51
  s_add_u32 s49, s50, s52
  buffer_load_dwordx4 v121, s[60:63], s49 offen nt lds
  s_add_u32 s50, s50, 4096
  s_and_b32 s50, s50, 0x7000
  s_add_u32 m0, s50, s51
  s_add_u32 s49, s50, s52
  buffer_load_dwordx4 v121, s[60:63], s49 offen nt lds
  s_add_u32 s50, s50, 4096
  s_and_b32 s50, s50, 0x7000
  s_add_u32 m0, s50, s51
  s_add_u32 s49, s50, s52
  buffer_load_dwordx4 v121, s[60:63], s49 offen nt lds
  s_add_u32 s50, s50, 4096
  s_and_b32 s50, s50, 0x7000
  s_add_u32 m0, s50, s51
  s_add_u32 s49, s50, s52
  buffer_load_dwordx4 v121, s[60:63], s49 offen nt lds
  s_waitcnt vmcnt(4)
Lxq_6:
  v_xor_b32 v24, s11, v24
  v_xor_b32 v25, s12, v25
  v_xor_b32 v26, s13, v26
  v_xor_b32 v27, s14, v27
  v_or3_b32 v9, v24, v25, v26
  v_bitop3_b32 v9, v9, v27, 15 bitop3:0xa8
  v_cmp_ne_u32 s[16:17], 0, v9
  v_xor_b32 v28, s11, v28
  v_xor_b32 v29, s12, v29
  v_xor_b32 v30, s13, v30
  v_xor_b32 v31, s14, v31
  v_or3_b32 v9, v28, v29, v30
  v_bitop3_b32 v9, v9, v31, 15 bitop3:0xa8
  v_cmp_ne_u32 s[18:19], 0, v9
  v_xor_b32 v32, s11, v32
  v_xor_b32 v33, s12, v33
  v_xor_b32 v34, s13, v34
  v_xor_b32 v35, s14, v35
  v_or3_b32 v9, v32, v33, v34
  v_bitop3_b32 v9, v9, v35, 15 bitop3:0xa8
  v_cmp_ne_u32 s[20:21], 0, v9
  v_xor_b32 v36, s11, v36
  v_xor_b32 v37, s12, v37
  v_xor_b32 v38, s13, v38
  v_xor_b32 v39, s14, v39
  v_or3_b32 v9, v36, v37, v38
  v_bitop3_b32 v9, v9, v39, 15 bitop3:0xa8
  v_cmp_ne_u32 s[22:23], 0, v9
  s_or_b64 vcc, s[16:17], s[18:19]
  s_or_b64 vcc, vcc, s[20:21]
  s_or_b64 vcc, vcc, s[22:23]
  s_cbranch_scc1 Lrt_2
Lok_4:
  v_pk_add_f32 v[24:25], v[24:25], v[32:33]
  v_pk_add_f32 v[26:27], v[26:27], v[34:35]
  v_pk_add_f32 v[28:29], v[28:29], v[36:37]
  v_pk_add_f32 v[30:31], v[30:31], v[38:39]
  v_pk_add_f32 v[24:25], v[24:25], v[28:29]
  v_pk_add_f32 v[26:27], v[26:27], v[30:31]
  s_nop 1
  v_permlane32_swap_b32 v24, v26
  v_permlane32_swap_b32 v25, v27
  s_nop 0
  v_pk_add_f32 v[24:25], v[24:25], v[26:27]
  v_cvt_pk_bf16_f32 v24, v24, v25
  ds_write_b32 v18, v24 offset:4096
  s_waitcnt lgkmcnt(0)
  s_barrier
  ds_read_b128 v[40:43], v43 offset:12288
  ds_read_b128 v[44:47], v47 offset:12288
  ds_read_b128 v[48:51], v51 offset:12288
  ds_read_b128 v[52:55], v55 offset:12288
  ds_read_b128 v[24:27], v123 offset:4096
  ds_read_b128 v[28:31], v123 offset:4160
  ds_read_b128 v[32:35], v123 offset:4224
  ds_read_b128 v[36:39], v123 offset:4288
  s_mov_b32 s6, 0x3db504f3
  s_mov_b32 s7, 0x3fb8aa3b
  s_waitcnt lgkmcnt(3)
  v_mfma_f32_16x16x32_bf16 v[20:23], v[40:43], v[24:27], 0
  s_waitcnt lgkmcnt(2)
  v_mfma_f32_16x16x32_bf16 v[20:23], v[44:47], v[28:31], v[20:23]
  s_waitcnt lgkmcnt(1)
  v_mfma_f32_16x16x32_bf16 v[20:23], v[48:51], v[32:35], v[20:23]
  s_waitcnt lgkmcnt(0)
  v_mfma_f32_16x16x32_bf16 v[20:23], v[52:55], v[36:39], v[20:23]
  s_nop 7
  v_max3_f32 v11, v20, v21, v22
  v_cvt_pk_bf16_f32 v9, v20, v21
  v_max_f32 v11, v11, v23
  ds_max_f32 v124, v11 offset:64
  v_cvt_pk_bf16_f32 v10, v22, v23
  v_lshlrev_b32 v20, 16, v9
  v_and_b32 v21, 0xffff0000, v9
  v_lshlrev_b32 v22, 16, v10
  v_and_b32 v23, 0xffff0000, v10
  v_mul_f32 v20, s6, v20
  v_mul_f32 v21, s6, v21
  v_mul_f32 v22, s6, v22
  v_mul_f32 v23, s6, v23
  s_cmp_lt_u32 s4, 4
  s_cbranch_scc1 Lxp_11
  buffer_load_dwordx4 v[56:59], v120, s[40:43], s8 offen nt
  s_add_u32 s8, s8, 8192
  buffer_load_dwordx4 v[60:63], v120, s[40:43], s8 offen nt
  s_add_u32 s8, s8, 8192
  buffer_load_dwordx4 v[64:67], v120, s[40:43], s8 offen nt
  s_add_u32 s8, s8, 8192
Lxp_11:
  s_waitcnt lgkmcnt(0)
  s_barrier
  ds_read_b32 v11, v124 offset:64
  v_cvt_pk_bf16_f32 v9, v20, v21
  v_cvt_pk_bf16_f32 v10, v22, v23
  v_lshlrev_b32 v20, 16, v9
  v_and_b32 v21, 0xffff0000, v9
  v_lshlrev_b32 v22, 16, v10
  v_and_b32 v23, 0xffff0000, v10
  s_waitcnt lgkmcnt(0)
  v_cvt_pk_bf16_f32 v11, v11, v11
  v_lshlrev_b32 v11, 16, v11
  v_mul_f32 v11, s6, v11
  v_cvt_pk_bf16_f32 v11, v11, v11
  v_lshlrev_b32 v11, 16, v11
  v_mul_f32 v11, s7, v11
  v_fma_f32 v20, v20, s7, -v11
  v_fma_f32 v21, v21, s7, -v11
  v_fma_f32 v22, v22, s7, -v11
  v_fma_f32 v23, v23, s7, -v11
  v_exp_f32 v20, v20
  v_exp_f32 v21, v21
  v_exp_f32 v22, v22
  v_exp_f32 v23, v23
  v_cvt_pk_bf16_f32 v20, v20, v21
  v_cvt_pk_bf16_f32 v21, v22, v23
  ds_write_b64 v126, v[20:21] offset:8192
  s_cmp_lt_u32 s4, 4
  s_cbranch_scc1 Lxp_12
  buffer_load_dwordx4 v[68:71], v120, s[40:43], s8 offen nt
  s_add_u32 s8, s8, s57
  buffer_load_dwordx4 v[72:75], v120, s[40:43], s8 offen nt
  s_add_u32 s8, s8, 8192
  buffer_load_dwordx4 v[76:79], v120, s[40:43], s8 offen nt
  s_add_u32 s8, s8, 8192
Lxp_12:
  s_cmp_ge_u32 s4, 4
  s_cbranch_scc1 Lxv_13
  s_waitcnt vmcnt(0)
Lxv_13:
  s_waitcnt lgkmcnt(0)
  s_barrier
  ds_read_b128 v[40:43], v125 offset:8192
  ds_read_b64_tr_b16 v[104:105], v122 offset:0
  ds_read_b64_tr_b16 v[106:107], v122 offset:4096
  ds_read_b128 v[44:47], v125 offset:9216
  ds_read_b64_tr_b16 v[108:109], v122 offset:8192
  ds_read_b64_tr_b16 v[110:111], v122 offset:12288
  ds_read_b128 v[48:51], v125 offset:10240
  ds_read_b64_tr_b16 v[112:113], v122 offset:16384
  ds_read_b64_tr_b16 v[114:115], v122 offset:20480
  ds_read_b128 v[52:55], v125 offset:11264
  ds_read_b64_tr_b16 v[116:117], v122 offset:24576
  ds_read_b64_tr_b16 v[118:119], v122 offset:28672
  v_mov_b32 v23, s10
  s_waitcnt lgkmcnt(9)
  v_mfma_f32_16x16x32_bf16 v[24:27], v[12:15], v[40:43], 0
  v_mfma_f32_16x16x32_bf16 v[16:19], v[104:107], v[40:43], 0
  s_waitcnt lgkmcnt(6)
  v_mfma_f32_16x16x32_bf16 v[24:27], v[12:15], v[44:47], v[24:27]
  v_mfma_f32_16x16x32_bf16 v[16:19], v[108:111], v[44:47], v[16:19]
  s_waitcnt lgkmcnt(3)
  v_mfma_f32_16x16x32_bf16 v[24:27], v[12:15], v[48:51], v[24:27]
  v_mfma_f32_16x16x32_bf16 v[16:19], v[112:115], v[48:51], v[16:19]
  s_waitcnt lgkmcnt(0)
  v_mfma_f32_16x16x32_bf16 v[24:27], v[12:15], v[52:55], v[24:27]
  v_mfma_f32_16x16x32_bf16 v[16:19], v[116:119], v[52:55], v[16:19]
  s_mov_b32 exec_lo, 0x00ff00ff
  s_mov_b32 exec_hi, 0x00ff00ff
  s_nop 4
  v_rcp_f32 v9, v24
  v_log_f32 v10, v24
  v_mul_f32 v16, v9, v16
  v_mul_f32 v17, v9, v17
  v_mul_f32 v18, v9, v18
  v_mul_f32 v19, v9, v19
  v_add_f32 v22, v11, v10
  v_cvt_pk_bf16_f32 v20, v16, v17
  v_cvt_pk_bf16_f32 v21, v18, v19
  buffer_store_dwordx4 v[20:23], v127, s[36:39], s58 offen sc1
  s_mov_b64 exec, -1
  s_cmp_lt_u32 s4, 4
  s_cbranch_scc1 L_XA2
L_YA2:
  s_setprio 0
  s_waitcnt vmcnt(5)
  buffer_load_dwordx4 v[80:83], v120, s[40:43], s8 offen nt
  s_add_u32 s8, s8, 8192
  s_waitcnt vmcnt(5)
  buffer_load_dwordx4 v[84:87], v120, s[40:43], s8 offen nt
  s_add_u32 s8, s8, s57
  s_waitcnt vmcnt(5)
  buffer_load_dwordx4 v[88:91], v120, s[40:43], s8 offen nt
  s_add_u32 s8, s8, 8192
  s_waitcnt vmcnt(5)
  buffer_load_dwordx4 v[92:95], v120, s[40:43], s8 offen nt
  s_add_u32 s8, s8, 8192
  s_waitcnt vmcnt(5)
  buffer_load_dwordx4 v[96:99], v120, s[40:43], s8 offen nt
  s_add_u32 s8, s8, 8192
  s_waitcnt vmcnt(5)
  buffer_load_dwordx4 v[100:103], v120, s[40:43], s8 offen nt
  s_add_u32 s8, s8, s57
  s_waitcnt vmcnt(7)
  buffer_load_dwordx4 v[104:107], v120, s[40:43], s8 offen nt
  s_add_u32 s8, s8, 8192
  s_waitcnt vmcnt(7)
  buffer_load_dwordx4 v[108:111], v120, s[40:43], s8 offen nt
  s_add_u32 s8, s8, 8192
  s_waitcnt vmcnt(7)
  buffer_load_dwordx4 v[112:115], v120, s[40:43], s8 offen nt
  s_add_u32 s8, s8, 8192
  s_waitcnt vmcnt(7)
  buffer_load_dwordx4 v[116:119], v120, s[40:43], s8 offen nt
  s_branch L_YL3
L_XA2:
  s_bfe_u32 s6, s2, 0x10002
  s_lshl_b32 s5, s6, 1
  s_add_u32 s5, s5, s2
  s_add_u32 s5, s5, 1
  s_and_b32 s5, s5, 3
  s_lshl_b32 s5, s5, 4
  s_lshr_b32 s7, s2, 3
  s_add_u32 s5, s5, s7
  s_lshl_b32 s5, s5, 1
  s_add_u32 s5, s5, s6
  s_lshr_b32 s8, s5, 5
  s_mul_i32 s8, s8, 135168
  s_bfe_u32 s6, s5, 0x30002
  s_lshl_b32 s6, s6, 9
  s_add_u32 s8, s8, s6
  s_bfe_u32 s6, s5, 0x10001
  s_lshl_b32 s6, s6, 6
  s_add_u32 s8, s8, s6
  s_lshl_b32 s6, s4, 7
  s_add_u32 s8, s8, s6
  s_add_u32 s8, s8, 393216
  s_add_u32 s9, s8, 67584
  v_lshrrev_b32 v125, 2, v0
  v_mul_u32_u24 v125, 4224, v125
  v_and_b32 v9, 3, v0
  v_lshl_add_u32 v125, v9, 4, v125
  v_and_b32 v9, 3, v0
  v_lshlrev_b32 v9, 3, v9
  v_and_b32 v10, 48, v0
  v_lshl_add_u32 v9, v10, 2, v9
  s_and_b32 s6, s4, 1
  s_lshl_b32 s6, s6, 5
  s_and_b32 s7, s4, 2
  s_lshl_b32 s7, s7, 1
  s_add_u32 s6, s6, s7
  v_add_u32 v2, s6, v9
  s_mov_b64 s[44:45], -1
  s_mov_b64 s[46:47], -1
  s_mov_b32 s7, 4000001
  s_waitcnt vmcnt(0)
Lil_14:
  s_wqm_b64 exec, s[44:45]
  s_cbranch_execz Lms_15
  buffer_load_dwordx4 v[24:27], v125, s[36:39], s8 offen sc1
Lms_15:
  s_wqm_b64 exec, s[46:47]
  s_cbranch_execz Lms_16
  buffer_load_dwordx4 v[28:31], v125, s[36:39], s9 offen sc1
Lms_16:
  s_sub_u32 s7, s7, 1
  s_cbranch_scc1 L_fail
  s_waitcnt vmcnt(0)
  v_cmp_ne_u32 s[46:47], s10, v31
  s_wqm_b64 exec, s[44:45]
  v_cmp_ne_u32 s[44:45], s10, v27
  s_mov_b64 exec, -1
  s_or_b64 vcc, s[44:45], s[46:47]
  s_cbranch_scc1 Lil_14
  v_max_f32 v16, v26, v30
  v_lshlrev_b32 v32, 16, v24
  v_and_b32 v33, 0xffff0000, v24
  v_max_f32_dpp v16, v16, v16 row_ror:4 row_mask:0xf bank_mask:0xf
  v_lshlrev_b32 v34, 16, v25
  v_and_b32 v35, 0xffff0000, v25
  v_max_f32_dpp v16, v16, v16 row_ror:8 row_mask:0xf bank_mask:0xf
  v_mov_b32 v9, v16
  v_lshlrev_b32 v40, 16, v28
  v_and_b32 v41, 0xffff0000, v28
  v_permlane16_swap_b32 v9, v16
  s_nop 0
  v_max_f32 v16, v9, v16
  v_mov_b32 v9, v16
  v_lshlrev_b32 v42, 16, v29
  v_and_b32 v43, 0xffff0000, v29
  v_permlane32_swap_b32 v9, v16
  s_nop 0
  v_max_f32 v16, v9, v16
  v_sub_f32 v26, v26, v16
  v_sub_f32 v30, v30, v16
  v_exp_f32 v26, v26
  v_exp_f32 v30, v30
  s_nop 0
  v_add_f32 v36, v26, v30
  v_mul_f32 v32, v26, v32
  v_mul_f32 v33, v26, v33
  v_mul_f32 v34, v26, v34
  v_mul_f32 v35, v26, v35
  v_fmac_f32 v32, v30, v40
  v_fmac_f32 v33, v30, v41
  v_fmac_f32 v34, v30, v42
  v_fmac_f32 v35, v30, v43
  v_mov_b32 v37, v36
  s_nop 0
  v_permlane32_swap_b32 v32, v34
  v_permlane32_swap_b32 v33, v35
  v_permlane32_swap_b32 v37, v36
  v_add_f32 v32, v32, v34
  v_add_f32 v33, v33, v35
  v_add_f32 v36, v36, v37
  v_mov_b32 v37, v36
  s_nop 0
  v_permlane16_swap_b32 v32, v33
  v_permlane16_swap_b32 v37, v36
  s_nop 0
  v_add_f32 v32, v32, v33
  v_add_f32 v36, v36, v37
  s_nop 0
  v_add_f32_dpp v32, v32, v32 row_ror:4 row_mask:0xf bank_mask:0xf
  v_add_f32_dpp v36, v36, v36 row_ror:4 row_mask:0xf bank_mask:0xf
  s_nop 0
  v_add_f32_dpp v32, v32, v32 row_ror:8 row_mask:0xf bank_mask:0xf
  v_add_f32_dpp v36, v36, v36 row_ror:8 row_mask:0xf bank_mask:0xf
  v_rcp_f32 v36, v36
  s_nop 0
  v_mul_f32 v32, v36, v32
L_oo:
  v_cvt_pk_bf16_f32 v32, v32, v32
  ds_write_b32 v2, v32 offset:512
  s_waitcnt lgkmcnt(0)
  s_barrier
L_oo2:
  s_sub_u32 s15, s2, 0
  s_mov_b32 s32, s34
  s_mov_b32 s33, s35
  s_mov_b32 s34, 0x800
  s_mov_b32 s35, 0x20000
  v_lshrrev_b32 v122, 2, v0
  v_mul_u32_u24 v122, 4224, v122
  v_and_b32 v9, 3, v0
  v_lshl_add_u32 v122, v9, 4, v122
  v_and_b32 v11, 15, v0
  v_and_b32 v10, 12, v0
  v_add_u32 v125, v11, v10
  v_lshlrev_b32 v125, 1, v125
  s_cmp_ge_u32 s15, 64
  s_cbranch_scc1 Lrs_17
  s_lshr_b32 s7, s15, 3
  s_and_b32 s5, s15, 7
  s_xor_b32 s5, s5, 4
  s_lshl_b32 s5, s5, 3
  s_add_u32 s5, s5, s7
  s_lshl_b32 s6, s4, 4
  s_mul_i32 s7, s4, 14
  s_add_u32 s7, s7, 8
  s_cmp_lt_u32 s4, 4
  s_cselect_b32 s6, s6, s7
  s_cselect_b32 s45, -1, 0x00ffffff
  s_mov_b32 s44, -1
  s_mul_i32 s6, s6, 4224
  s_mul_i32 s9, s5, 64
  s_add_u32 s9, s9, s6
  s_add_u32 s9, s9, 950272
  s_lshr_b32 s8, s5, 3
  s_lshl_b32 s8, s8, 8
  s_and_b32 s6, s5, 3
  s_lshl_b32 s6, s6, 6
  s_add_u32 s8, s8, s6
  s_and_b32 s6, s5, 4
  s_lshl_b32 s6, s6, 1
  s_add_u32 s8, s8, s6
  s_add_u32 s6, s8, 77824
  v_add_u32 v10, s6, v125
  ds_read_u16 v126, v10
  v_mov_b32 v44, 0
  v_mov_b32 v45, 0
  v_mov_b32 v46, 0
  v_mov_b32 v47, 0
  v_lshrrev_b32 v10, 4, v0
  v_lshl_add_u32 v9, v9, 2, v10
  v_mul_u32_u24 v123, 48, v9
  s_lshl_b32 s6, s4, 2
  v_add_u32 v123, s6, v123
  v_mul_u32_u24 v124, 48, v11
  v_mov_b32 v127, 0
  v_mov_b32 v43, 1
  s_mov_b32 s7, 4000001
  s_waitcnt lgkmcnt(0)
  v_lshlrev_b32 v126, 16, v126
Lrs_17:
  s_branch L_R
L_BX2:
  s_mov_b32 s36, s38
  s_mov_b32 s37, s39
  s_mov_b32 s38, 0x168000
  s_mov_b32 s39, 0x20000
  buffer_load_dword v124, off, s[36:39], 0 offset:0 sc1
  s_setprio 3
  s_lshl_b32 s7, s9, 9
  v_lshrrev_b32 v9, 3, v0
  v_lshl_add_u32 v120, v9, 6, s7
  v_and_b32 v9, 1, v0
  v_lshlrev_b32 v9, 4, v9
  v_mov_b32 v10, 0xffff
  v_lshlrev_b32 v10, v9, v10
  v_bfe_u32 v9, v0, 1, 2
  v_cmp_eq_u32 vcc, 0, v9
  s_nop 1
  v_cndmask_b32 v4, 0, v10, vcc
  v_cmp_eq_u32 vcc, 1, v9
  s_nop 1
  v_cndmask_b32 v5, 0, v10, vcc
  v_cmp_eq_u32 vcc, 2, v9
  s_nop 1
  v_cndmask_b32 v6, 0, v10, vcc
  v_cmp_eq_u32 vcc, 3, v9
  s_nop 1
  v_cndmask_b32 v7, 0, v10, vcc
  s_lshl_b32 s6, s6, 3
  s_add_u32 s6, s6, s9
  s_mul_i32 s6, s6, 14464
  s_add_u32 s56, s56, s6
  s_add_u32 s56, s56, 135168
  v_lshlrev_b32 v121, 4, v0
  v_lshrrev_b32 v122, 2, v0
  v_mul_u32_u24 v122, 14464, v122
  v_and_b32 v9, 3, v0
  v_lshl_add_u32 v122, v9, 4, v122
  s_and_b32 s6, s2, 7
  s_lshl_b32 s6, s6, 2
  s_lshr_b32 s9, 0x21030321, s6
  s_and_b32 s9, s9, 3
  s_mul_i32 s9, s9, 14
  s_sub_u32 s7, s2, 128
  s_lshr_b32 s7, s7, 3
  s_add_u32 s9, s9, s7
  s_lshl_b32 s9, s9, 1
  s_bfe_u32 s6, s2, 0x10002
  s_add_u32 s9, s9, s6
  s_bfe_u32 s6, s9, 0x10001
  s_lshl_b32 s6, s6, 7
  s_lshr_b32 s9, s9, 2
  s_lshl_b32 s9, s9, 9
  s_add_u32 s9, s9, s6
  s_and_b32 s6, s4, 2
  s_lshl_b32 s6, s6, 7
  s_add_u32 s9, s9, s6
  s_and_b32 s6, s4, 1
  s_lshl_b32 s6, s6, 6
  s_add_u32 s9, s9, s6
  s_add_u32 s9, s9, 135168
  v_and_b32 v9, 3, v0
  v_lshlrev_b32 v9, 2, v9
  v_and_b32 v10, 16, v0
  v_lshl_add_u32 v9, v10, 3, v9
  v_and_b32 v10, 32, v0
  v_lshl_add_u32 v9, v10, 1, v9
  s_lshl_b32 s6, s4, 4
  v_add_u32 v2, s6, v9
  s_waitcnt vmcnt(4)
  buffer_load_dwordx4 v[76:79], v1, s[40:43], s8 offen nt
  s_sub_u32 s8, s8, 107520
  s_waitcnt vmcnt(4)
  buffer_load_dwordx4 v[80:83], v1, s[40:43], s8 offen nt
  s_add_u32 s8, s8, 114688
  s_waitcnt vmcnt(4)
  buffer_load_dwordx4 v[84:87], v1, s[40:43], s8 offen nt
  s_sub_u32 s8, s8, 107520
  s_waitcnt vmcnt(4)
  buffer_load_dwordx4 v[88:91], v1, s[40:43], s8 offen nt
  s_add_u32 s8, s8, 114688
  s_waitcnt vmcnt(4)
  buffer_load_dwordx4 v[92:95], v1, s[40:43], s8 offen nt
  s_sub_u32 s8, s8, 107520
  s_waitcnt vmcnt(4)
  buffer_load_dwordx4 v[96:99], v1, s[40:43], s8 offen nt
  s_add_u32 s8, s8, 114688
  s_waitcnt vmcnt(4)
  buffer_load_dwordx4 v[100:103], v1, s[40:43], s8 offen nt
  s_sub_u32 s8, s8, 107520
  s_waitcnt vmcnt(4)
  buffer_load_dwordx4 v[104:107], v1, s[40:43], s8 offen nt
  s_add_u32 s8, s8, 114688
  s_waitcnt vmcnt(4)
  buffer_load_dwordx4 v[108:111], v1, s[40:43], s8 offen nt
  s_sub_u32 s8, s8, 107520
  s_waitcnt vmcnt(4)
  buffer_load_dwordx4 v[112:115], v1, s[40:43], s8 offen nt
  s_add_u32 s8, s8, 114688
  s_barrier
  ds_read_b128 v[24:27], v120 offset:8192
  ds_read_b128 v[28:31], v120 offset:8208
  ds_read_b128 v[32:35], v120 offset:8224
  ds_read_b128 v[36:39], v120 offset:8240
  s_waitcnt lgkmcnt(3)
  v_and_b32 v12, v24, v4
  v_and_b32 v13, v24, v5
  v_and_b32 v14, v24, v6
  v_and_b32 v15, v24, v7
  v_and_b32 v16, v25, v4
  v_and_b32 v17, v25, v5
  s_waitcnt vmcnt(15)
  v_mfma_f32_16x16x32_bf16 v[20:23], v[12:15], v[56:59], 0
  v_and_b32 v18, v25, v6
  v_and_b32 v19, v25, v7
  s_waitcnt vmcnt(14)
  v_mfma_f32_16x16x32_bf16 v[48:51], v[12:15], v[60:63], 0
  v_and_b32 v12, v26, v4
  v_and_b32 v13, v26, v5
  s_waitcnt vmcnt(13)
  v_mfma_f32_16x16x32_bf16 v[20:23], v[16:19], v[64:67], v[20:23]
  v_and_b32 v14, v26, v6
  v_and_b32 v15, v26, v7
  s_waitcnt vmcnt(12)
  v_mfma_f32_16x16x32_bf16 v[48:51], v[16:19], v[68:71], v[48:51]
  s_waitcnt lgkmcnt(0)
  v_and_b32 v16, v27, v4
  v_and_b32 v17, v27, v5
  s_waitcnt vmcnt(11)
  v_mfma_f32_16x16x32_bf16 v[20:23], v[12:15], v[72:75], v[20:23]
  v_and_b32 v18, v27, v6
  v_and_b32 v19, v27, v7
  s_waitcnt vmcnt(9)
  v_mfma_f32_16x16x32_bf16 v[48:51], v[12:15], v[76:79], v[48:51]
  v_and_b32 v12, v28, v4
  v_and_b32 v13, v28, v5
  s_waitcnt vmcnt(8)
  v_mfma_f32_16x16x32_bf16 v[20:23], v[16:19], v[80:83], v[20:23]
  v_and_b32 v14, v28, v6
  v_and_b32 v15, v28, v7
  s_waitcnt vmcnt(7)
  v_mfma_f32_16x16x32_bf16 v[48:51], v[16:19], v[84:87], v[48:51]
  v_and_b32 v16, v29, v4
  v_and_b32 v17, v29, v5
  s_waitcnt vmcnt(6)
  v_mfma_f32_16x16x32_bf16 v[20:23], v[12:15], v[88:91], v[20:23]
  v_and_b32 v18, v29, v6
  v_and_b32 v19, v29, v7
  s_waitcnt vmcnt(5)
  v_mfma_f32_16x16x32_bf16 v[48:51], v[12:15], v[92:95], v[48:51]
  v_and_b32 v12, v30, v4
  v_and_b32 v13, v30, v5
  s_waitcnt vmcnt(4)
  buffer_load_dwordx4 v[116:119], v1, s[40:43], s8 offen nt
  s_sub_u32 s8, s8, 107520
  v_mfma_f32_16x16x32_bf16 v[20:23], v[16:19], v[96:99], v[20:23]
  v_and_b32 v14, v30, v6
  v_and_b32 v15, v30, v7
  s_waitcnt vmcnt(4)
  buffer_load_dwordx4 v[56:59], v1, s[40:43], s8 offen nt
  s_add_u32 s8, s8, 114688
  v_mfma_f32_16x16x32_bf16 v[48:51], v[16:19], v[100:103], v[48:51]
  v_and_b32 v16, v31, v4
  v_and_b32 v17, v31, v5
  s_waitcnt vmcnt(4)
  buffer_load_dwordx4 v[60:63], v1, s[40:43], s8 offen nt
  s_sub_u32 s8, s8, 107520
  v_mfma_f32_16x16x32_bf16 v[20:23], v[12:15], v[104:107], v[20:23]
  v_and_b32 v18, v31, v6
  v_and_b32 v19, v31, v7
  s_waitcnt vmcnt(4)
  buffer_load_dwordx4 v[64:67], v1, s[40:43], s8 offen nt
  s_add_u32 s8, s8, 114688
  v_mfma_f32_16x16x32_bf16 v[48:51], v[12:15], v[108:111], v[48:51]
  v_and_b32 v12, v32, v4
  v_and_b32 v13, v32, v5
  s_waitcnt vmcnt(4)
  buffer_load_dwordx4 v[68:71], v1, s[40:43], s8 offen nt
  s_sub_u32 s8, s8, 107520
  v_mfma_f32_16x16x32_bf16 v[20:23], v[16:19], v[112:115], v[20:23]
  v_and_b32 v14, v32, v6
  v_and_b32 v15, v32, v7
  s_waitcnt vmcnt(4)
  buffer_load_dwordx4 v[72:75], v1, s[40:43], s8 offen nt
  s_add_u32 s8, s8, 114688
  v_mfma_f32_16x16x32_bf16 v[48:51], v[16:19], v[116:119], v[48:51]
  v_and_b32 v16, v33, v4
  v_and_b32 v17, v33, v5
  s_waitcnt vmcnt(4)
  buffer_load_dwordx4 v[76:79], v1, s[40:43], s8 offen nt
  s_sub_u32 s8, s8, 107520
  v_mfma_f32_16x16x32_bf16 v[20:23], v[12:15], v[56:59], v[20:23]
  v_and_b32 v18, v33, v6
  v_and_b32 v19, v33, v7
  s_waitcnt vmcnt(4)
  buffer_load_dwordx4 v[80:83], v1, s[40:43], s8 offen nt
  s_add_u32 s8, s8, 114688
  v_mfma_f32_16x16x32_bf16 v[48:51], v[12:15], v[60:63], v[48:51]
  v_and_b32 v12, v34, v4
  v_and_b32 v13, v34, v5
  s_waitcnt vmcnt(4)
  buffer_load_dwordx4 v[84:87], v1, s[40:43], s8 offen nt
  s_sub_u32 s8, s8, 107520
  buffer_load_dwordx4 v[88:91], v1, s[40:43], s8 offen nt
  s_add_u32 s8, s8, 114688
  v_mfma_f32_16x16x32_bf16 v[20:23], v[16:19], v[64:67], v[20:23]
  v_and_b32 v14, v34, v6
  v_and_b32 v15, v34, v7
  s_waitcnt vmcnt(5)
  buffer_load_dwordx4 v[92:95], v1, s[40:43], s8 offen nt
  s_sub_u32 s8, s8, 107520
  v_mfma_f32_16x16x32_bf16 v[48:51], v[16:19], v[68:71], v[48:51]
  v_and_b32 v16, v35, v4
  v_and_b32 v17, v35, v5
  s_waitcnt vmcnt(5)
  buffer_load_dwordx4 v[96:99], v1, s[40:43], s8 offen nt
  s_add_u32 s8, s8, 114688
  v_mfma_f32_16x16x32_bf16 v[20:23], v[12:15], v[72:75], v[20:23]
  v_readfirstlane_b32 s10, v124
  s_nop 0
  s_add_u32 s10, s10, 0x9e3779b9
  s_bfe_u32 s11, s10, 0x40000
  s_bfe_u32 s12, s10, 0x40004
  s_bfe_u32 s13, s10, 0x40008
  s_bfe_u32 s14, s10, 0x4000c
  v_and_b32 v18, v35, v6
  v_and_b32 v19, v35, v7
  s_waitcnt vmcnt(5)
  buffer_load_dwordx4 v[100:103], v1, s[40:43], s8 offen nt
  s_sub_u32 s8, s8, 107520
  v_mfma_f32_16x16x32_bf16 v[48:51], v[12:15], v[76:79], v[48:51]
  v_and_b32 v12, v36, v4
  v_and_b32 v13, v36, v5
  s_waitcnt vmcnt(5)
  buffer_load_dwordx4 v[104:107], v1, s[40:43], s8 offen nt
  s_add_u32 s8, s8, 114688
  v_mfma_f32_16x16x32_bf16 v[20:23], v[16:19], v[80:83], v[20:23]
  v_and_b32 v14, v36, v6
  v_and_b32 v15, v36, v7
  s_waitcnt vmcnt(5)
  buffer_load_dwordx4 v[108:111], v1, s[40:43], s8 offen nt
  s_sub_u32 s8, s8, 107520
  v_mfma_f32_16x16x32_bf16 v[48:51], v[16:19], v[84:87], v[48:51]
  v_and_b32 v16, v37, v4
  v_and_b32 v17, v37, v5
  s_waitcnt vmcnt(5)
  buffer_load_dwordx4 v[112:115], v1, s[40:43], s8 offen nt
  s_add_u32 s8, s8, 114688
  v_mfma_f32_16x16x32_bf16 v[20:23], v[12:15], v[88:91], v[20:23]
  v_and_b32 v18, v37, v6
  v_and_b32 v19, v37, v7
  s_waitcnt vmcnt(5)
  buffer_load_dwordx4 v[116:119], v1, s[40:43], s8 offen nt
  v_mfma_f32_16x16x32_bf16 v[48:51], v[12:15], v[92:95], v[48:51]
  v_and_b32 v12, v38, v4
  v_and_b32 v13, v38, v5
  s_waitcnt vmcnt(5)
  v_mfma_f32_16x16x32_bf16 v[20:23], v[16:19], v[96:99], v[20:23]
  v_and_b32 v14, v38, v6
  v_and_b32 v15, v38, v7
  s_waitcnt vmcnt(4)
  s_barrier
  v_mfma_f32_16x16x32_bf16 v[48:51], v[16:19], v[100:103], v[48:51]
  v_and_b32 v16, v39, v4
  v_and_b32 v17, v39, v5
  s_waitcnt vmcnt(3)
  v_mfma_f32_16x16x32_bf16 v[20:23], v[12:15], v[104:107], v[20:23]
  v_and_b32 v18, v39, v6
  v_and_b32 v19, v39, v7
  s_waitcnt vmcnt(2)
  v_mfma_f32_16x16x32_bf16 v[48:51], v[12:15], v[108:111], v[48:51]
  s_waitcnt vmcnt(1)
  v_mfma_f32_16x16x32_bf16 v[20:23], v[16:19], v[112:115], v[20:23]
  s_waitcnt vmcnt(0)
  v_mfma_f32_16x16x32_bf16 v[48:51], v[16:19], v[116:119], v[48:51]
  s_nop 7
  v_permlane32_swap_b32 v48, v24
  v_permlane32_swap_b32 v49, v25
  v_permlane32_swap_b32 v50, v26
  v_permlane32_swap_b32 v51, v27
  s_mov_b32 exec_hi, 0
  v_pk_add_f32 v[20:21], v[20:21], v[24:25]
  v_pk_add_f32 v[22:23], v[22:23], v[26:27]
  v_add_u32 v20, 8, v20
  v_add_u32 v21, 8, v21
  v_add_u32 v22, 8, v22
  v_add_u32 v23, 8, v23
  v_bfi_b32 v20, 15, s11, v20
  v_bfi_b32 v21, 15, s12, v21
  v_bfi_b32 v22, 15, s13, v22
  v_bfi_b32 v23, 15, s14, v23
  buffer_store_dwordx4 v[20:23], v121, s[36:39], s56 offen sc1
  s_mov_b64 exec, -1
  s_mov_b64 s[44:45], -1
  s_mov_b32 s7, 4000001
  s_waitcnt vmcnt(0)
Lil_18:
  s_wqm_b64 exec, s[44:45]
  buffer_load_dwordx4 v[28:31], v122, s[36:39], s9 offen sc1
  s_sub_u32 s7, s7, 1
  s_cbranch_scc1 L_fail
  s_waitcnt vmcnt(0)
  v_xor_b32 v28, s11, v28
  v_xor_b32 v29, s12, v29
  v_xor_b32 v30, s13, v30
  v_xor_b32 v31, s14, v31
  v_or3_b32 v9, v28, v29, v30
  v_bitop3_b32 v9, v9, v31, 15 bitop3:0xa8
  v_cmp_ne_u32 s[44:45], 0, v9
  s_mov_b64 exec, -1
  s_cmp_lg_u64 s[44:45], 0
  s_cbranch_scc1 Lil_18
  v_permlane16_swap_b32 v28, v30
  v_permlane16_swap_b32 v29, v31
  s_nop 0
  v_add_f32 v28, v28, v30
  v_add_f32 v29, v29, v31
  s_nop 0
  v_add_f32_dpp v28, v28, v28 row_ror:4 row_mask:0xf bank_mask:0xf
  v_add_f32_dpp v29, v29, v29 row_ror:4 row_mask:0xf bank_mask:0xf
  s_nop 0
  v_add_f32_dpp v28, v28, v28 row_ror:8 row_mask:0xf bank_mask:0xf
  v_add_f32_dpp v29, v29, v29 row_ror:8 row_mask:0xf bank_mask:0xf
  s_nop 1
  v_permlane32_swap_b32 v28, v29
  s_nop 0
  v_cvt_pk_bf16_f32 v28, v28, v29
  v_lshlrev_b32 v32, 16, v28
  v_mul_f32 v32, 0xbfb8aa3b, v32
  v_exp_f32 v32, v32
  v_and_b32 v29, 0xffff0000, v28
  v_add_f32 v32, 1.0, v32
  v_rcp_f32 v32, v32
  s_nop 0
  v_cvt_pk_bf16_f32 v32, v32, v32
  v_lshlrev_b32 v32, 16, v32
  v_mul_f32 v32, v32, v29
  v_cvt_pk_bf16_f32 v32, v32, v32
  ds_write_b32 v2, v32 offset:512
  s_waitcnt lgkmcnt(0)
  s_barrier
  s_branch L_oo2
L_Y:
  s_lshl_b32 s9, s9, 1
  v_lshl_add_u32 v122, v0, 4, s9
  v_mov_b32 v9, 0
  v_mov_b32 v44, 0
  v_mov_b32 v45, 0
  v_mov_b32 v46, 0
  v_mov_b32 v47, 0
  ds_write_b128 v9, v[44:47] offset:0
  v_lshlrev_b32 v10, 2, v3
  v_mov_b32 v11, 0xff800000
  ds_write_b32 v10, v11 offset:64
  v_lshlrev_b32 v120, 11, v2
  v_lshl_add_u32 v120, v3, 4, v120
  v_lshrrev_b32 v121, 2, v0
  v_mul_u32_u24 v121, 64, v121
  v_and_b32 v10, 3, v0
  v_lshl_add_u32 v121, v10, 4, v121
  v_mov_b32 v12, 0x3f803f80
  v_mov_b32 v10, 0
  v_mov_b32 v11, 0x3a800000
  s_waitcnt vmcnt(1)
  v_lshrrev_b32 v1, 1, v122
  v_add_u32 v1, 77824, v1
  ds_write_b64 v1, v[110:111]
  v_dot2c_f32_bf16 v9, v12, v112
  v_dot2c_f32_bf16 v10, v12, v113
  v_dot2c_f32_bf16 v9, v12, v114
  v_dot2c_f32_bf16 v10, v12, v115
  v_dot2c_f32_bf16 v9, v12, v116
  v_dot2c_f32_bf16 v10, v12, v117
  v_dot2c_f32_bf16 v9, v12, v118
  v_dot2c_f32_bf16 v10, v12, v119
  v_lshlrev_b32 v28, 16, v112
  v_and_b32 v29, 0xffff0000, v112
  v_lshlrev_b32 v30, 16, v113
  v_add_f32 v9, v9, v10
  v_and_b32 v31, 0xffff0000, v113
  v_lshlrev_b32 v32, 16, v114
  v_add_f32_dpp v9, v9, v9 row_ror:8 row_mask:0xf bank_mask:0xf
  v_and_b32 v33, 0xffff0000, v114
  v_lshlrev_b32 v34, 16, v115
  v_add_f32_dpp v9, v9, v9 row_ror:4 row_mask:0xf bank_mask:0xf
  v_and_b32 v35, 0xffff0000, v115
  v_lshlrev_b32 v36, 16, v116
  v_add_f32_dpp v9, v9, v9 row_ror:2 row_mask:0xf bank_mask:0xf
  v_and_b32 v37, 0xffff0000, v116
  v_lshlrev_b32 v38, 16, v117
  v_add_f32_dpp v9, v9, v9 row_ror:1 row_mask:0xf bank_mask:0xf
  v_and_b32 v39, 0xffff0000, v117
  v_lshlrev_b32 v40, 16, v118
  v_add_f32_dpp v9, v9, v9 row_bcast:15 row_mask:0xa bank_mask:0xf
  v_and_b32 v41, 0xffff0000, v118
  v_lshlrev_b32 v42, 16, v119
  v_add_f32_dpp v9, v9, v9 row_bcast:31 row_mask:0xc bank_mask:0xf
  v_and_b32 v43, 0xffff0000, v119
  v_readlane_b32 s6, v9, 63
  s_nop 0
  s_nop 0
  v_mul_f32 v2, s6, v11
  v_mul_f32 v3, s6, v11
  v_pk_add_f32 v[28:29], v[28:29], v[2:3] neg_lo:[0,1] neg_hi:[0,1]
  v_pk_add_f32 v[30:31], v[30:31], v[2:3] neg_lo:[0,1] neg_hi:[0,1]
  v_pk_add_f32 v[32:33], v[32:33], v[2:3] neg_lo:[0,1] neg_hi:[0,1]
  v_pk_add_f32 v[34:35], v[34:35], v[2:3] neg_lo:[0,1] neg_hi:[0,1]
  v_pk_add_f32 v[36:37], v[36:37], v[2:3] neg_lo:[0,1] neg_hi:[0,1]
  v_pk_add_f32 v[38:39], v[38:39], v[2:3] neg_lo:[0,1] neg_hi:[0,1]
  v_pk_add_f32 v[40:41], v[40:41], v[2:3] neg_lo:[0,1] neg_hi:[0,1]
  v_pk_add_f32 v[42:43], v[42:43], v[2:3] neg_lo:[0,1] neg_hi:[0,1]
  v_pk_fma_f32 v[44:45], v[28:29], v[28:29], v[44:45]
  v_pk_fma_f32 v[46:47], v[30:31], v[30:31], v[46:47]
  v_pk_fma_f32 v[44:45], v[32:33], v[32:33], v[44:45]
  v_pk_fma_f32 v[46:47], v[34:35], v[34:35], v[46:47]
  v_pk_fma_f32 v[44:45], v[36:37], v[36:37], v[44:45]
  v_pk_fma_f32 v[46:47], v[38:39], v[38:39], v[46:47]
  v_pk_fma_f32 v[44:45], v[40:41], v[40:41], v[44:45]
  v_pk_fma_f32 v[46:47], v[42:43], v[42:43], v[46:47]
  v_pk_add_f32 v[44:45], v[44:45], v[46:47]
  v_add_f32 v9, v44, v45
  v_lshlrev_b32 v24, 16, v110
  v_and_b32 v25, 0xffff0000, v110
  v_add_f32_dpp v9, v9, v9 row_ror:8 row_mask:0xf bank_mask:0xf
  v_lshlrev_b32 v26, 16, v111
  v_and_b32 v27, 0xffff0000, v111
  v_add_f32_dpp v9, v9, v9 row_ror:4 row_mask:0xf bank_mask:0xf
  v_cvt_pk_bf16_f32 v3, v3, v3
  v_lshlrev_b32 v3, 16, v3
  v_add_f32_dpp v9, v9, v9 row_ror:2 row_mask:0xf bank_mask:0xf
  v_sub_f32 v24, v24, v3
  v_sub_f32 v25, v25, v3
  v_add_f32_dpp v9, v9, v9 row_ror:1 row_mask:0xf bank_mask:0xf
  v_sub_f32 v26, v26, v3
  v_sub_f32 v27, v27, v3
  v_add_f32_dpp v9, v9, v9 row_bcast:15 row_mask:0xa bank_mask:0xf
  v_cvt_pk_bf16_f32 v10, v24, v25
  v_cvt_pk_bf16_f32 v2, v26, v27
  v_add_f32_dpp v9, v9, v9 row_bcast:31 row_mask:0xc bank_mask:0xf
  v_lshlrev_b32 v24, 16, v10
  v_readlane_b32 s6, v9, 63
  v_and_b32 v25, 0xffff0000, v10
  v_lshlrev_b32 v26, 16, v2
  v_mul_f32 v9, s6, v11
  v_cvt_pk_bf16_f32 v9, v9, v9
  v_lshlrev_b32 v9, 16, v9
  v_add_f32 v9, 0x3727c5ac, v9
  v_cvt_pk_bf16_f32 v9, v9, v9
  v_lshlrev_b32 v9, 16, v9
  v_sqrt_f32 v9, v9
  v_and_b32 v27, 0xffff0000, v2
  v_cvt_pk_bf16_f32 v9, v9, v9
  v_lshlrev_b32 v9, 16, v9
  v_rcp_f32 v9, v9
  s_nop 0
  v_mul_f32 v24, v24, v9
  v_mul_f32 v25, v25, v9
  v_mul_f32 v26, v26, v9
  v_mul_f32 v27, v27, v9
  v_cvt_pk_bf16_f32 v24, v24, v24
  v_cvt_pk_bf16_f32 v25, v25, v25
  v_cvt_pk_bf16_f32 v26, v26, v26
  v_cvt_pk_bf16_f32 v27, v27, v27
  ds_write_b128 v122, v[24:27] offset:8192
  s_waitcnt lgkmcnt(0) vmcnt(0)
  s_barrier
  v_readfirstlane_b32 s10, v124
  s_nop 0
  s_add_u32 s10, s10, 0x9e3779b9
  s_bfe_u32 s11, s10, 0x40000
  s_bfe_u32 s12, s10, 0x40004
  s_bfe_u32 s13, s10, 0x40008
  s_bfe_u32 s14, s10, 0x4000c
  v_and_b32 v9, 1, v0
  v_lshlrev_b32 v9, 4, v9
  v_mov_b32 v10, 0xffff
  v_lshlrev_b32 v10, v9, v10
  v_bfe_u32 v9, v0, 1, 2
  v_cmp_eq_u32 vcc, 0, v9
  s_nop 1
  v_cndmask_b32 v4, 0, v10, vcc
  v_cmp_eq_u32 vcc, 1, v9
  s_nop 1
  v_cndmask_b32 v5, 0, v10, vcc
  v_cmp_eq_u32 vcc, 2, v9
  s_nop 1
  v_cndmask_b32 v6, 0, v10, vcc
  v_cmp_eq_u32 vcc, 3, v9
  s_nop 1
  v_cndmask_b32 v7, 0, v10, vcc
  s_cmp_ge_u32 s2, 128
  s_cbranch_scc1 L_YB2
  s_bfe_u32 s6, s2, 0x10002
  s_lshl_b32 s5, s6, 1
  s_add_u32 s5, s5, s2
  s_add_u32 s5, s5, 1
  s_and_b32 s5, s5, 3
  s_lshl_b32 s5, s5, 4
  s_lshr_b32 s7, s2, 3
  s_add_u32 s5, s5, s7
  s_lshl_b32 s5, s5, 1
  s_add_u32 s5, s5, s6
  s_lshr_b32 s9, s5, 1
  s_lshr_b32 s8, s5, 5
  s_lshl_b32 s8, s8, 21
  s_bfe_u32 s6, s5, 0x10001
  s_lshl_b32 s6, s6, 20
  s_add_u32 s8, s8, s6
  s_bfe_u32 s6, s5, 0x30002
  s_lshl_b32 s6, s6, 15
  s_add_u32 s8, s8, s6
  s_mov_b32 s57, 237568
  s_and_b32 s6, s5, 1
  s_lshl_b32 s6, s6, 2
  s_add_u32 s6, s6, s4
  s_sub_u32 s6, s6, 4
  s_lshl_b32 s7, s6, 8
  s_add_u32 s8, s8, s7
  s_mul_i32 s59, s6, 512
  s_mul_i32 s9, s9, 4224
  s_add_u32 s59, s59, s9
  s_add_u32 s59, s59, 950272
  s_mov_b32 s40, s24
  s_mov_b32 s41, s25
  s_mov_b32 s42, 0x800000
  s_and_b32 s5, s2, 7
  s_lshl_b32 s5, s5, 4
  s_lshr_b32 s6, s2, 3
  s_add_u32 s5, s5, s6
  v_lshrrev_b32 v2, 4, v0
  v_and_b32 v3, 15, v0
  v_xor_b32 v10, v2, v3
  v_lshlrev_b32 v10, 4, v10
  v_lshl_add_u32 v1, v3, 8, v10
  s_lshl_b32 s6, s4, 12
  v_xor_b32 v10, 0, v1
  v_add_u32 v43, s6, v10
  v_xor_b32 v10, 64, v1
  v_add_u32 v47, s6, v10
  v_xor_b32 v10, 128, v1
  v_add_u32 v51, s6, v10
  v_xor_b32 v10, 192, v1
  v_add_u32 v55, s6, v10
  v_lshrrev_b32 v1, 2, v0
  v_and_b32 v9, 7, v1
  v_xor_b32 v9, s4, v9
  v_lshlrev_b32 v9, 5, v9
  v_and_b32 v10, 3, v0
  v_lshl_add_u32 v9, v10, 3, v9
  v_lshl_add_u32 v9, v1, 8, v9
  v_add_u32 v122, 45056, v9
  v_and_b32 v1, 7, v0
  v_mul_u32_u24 v123, 272, v1
  v_lshl_add_u32 v123, v2, 4, v123
  v_lshlrev_b32 v124, 2, v3
  s_lshr_b32 s6, s4, 1
  s_lshl_b32 s6, s6, 10
  s_and_b32 s7, s4, 1
  s_lshl_b32 s7, s7, 3
  s_add_u32 s6, s6, s7
  v_lshlrev_b32 v125, 4, v0
  v_add_u32 v126, s6, v125
  v_lshlrev_b32 v127, 4, v3
  v_lshl_add_u32 v127, v2, 7, v127
  s_mul_i32 s58, s5, 4224
  s_lshl_b32 s7, s4, 9
  s_add_u32 s58, s58, s7
  s_add_u32 s58, s58, 393216
  v_mov_b32 v12, 0x3f803f80
  v_mov_b32 v13, v12
  v_mov_b32 v14, v12
  v_mov_b32 v15, v12
  s_lshr_b32 s9, s5, 5
  s_lshl_b32 s9, s9, 15
  s_add_u32 s9, s9, s7
  s_add_u32 s9, s9, 4096
  s_add_u32 s56, s9, 8192
  v_lshrrev_b32 v9, 5, v0
  v_and_b32 v10, 31, v0
  v_lshlrev_b32 v16, 12, v9
  v_lshl_add_u32 v16, v10, 4, v16
  v_add_u32 v17, 16384, v16
  s_mul_i32 s6, s4, 272
  v_lshlrev_b32 v18, 4, v3
  v_lshl_add_u32 v18, v9, 2, v18
  v_and_b32 v10, 1, v2
  v_lshl_add_u32 v18, v10, 3, v18
  v_add_u32 v18, s6, v18
  s_branch L_att
L_YB2:
  s_and_b32 s6, s2, 7
  s_lshl_b32 s6, s6, 2
  s_lshr_b32 s5, 0x21030321, s6
  s_and_b32 s5, s5, 3
  s_mul_i32 s5, s5, 14
  s_sub_u32 s7, s2, 128
  s_lshr_b32 s7, s7, 3
  s_add_u32 s5, s5, s7
  s_lshl_b32 s5, s5, 1
  s_bfe_u32 s6, s2, 0x10002
  s_add_u32 s5, s5, s6
  s_lshr_b32 s9, s5, 1
  s_lshl_b32 s8, s9, 17
  s_movk_i32 s57, 8192
  s_and_b32 s6, s5, 1
  s_lshl_b32 s6, s6, 2
  s_add_u32 s6, s6, s4
  s_sub_u32 s6, s6, 4
  s_lshl_b32 s7, s6, 8
  s_add_u32 s8, s8, s7
  s_mul_i32 s59, s6, 512
  s_mul_i32 s9, s9, 4224
  s_add_u32 s59, s59, s9
  s_add_u32 s59, s59, 1220608
  s_mov_b32 s40, s32
  s_mov_b32 s41, s33
  s_mov_b32 s42, 7340032
  s_setprio 0
  s_barrier
  buffer_load_dwordx4 v[56:59], v120, s[40:43], s8 offen nt
  s_add_u32 s8, s8, 8192
  buffer_load_dwordx4 v[60:63], v120, s[40:43], s8 offen nt
  s_add_u32 s8, s8, 8192
  buffer_load_dwordx4 v[64:67], v120, s[40:43], s8 offen nt
  s_add_u32 s8, s8, 8192
  buffer_load_dwordx4 v[68:71], v120, s[40:43], s8 offen nt
  s_add_u32 s8, s8, s57
  buffer_load_dwordx4 v[72:75], v120, s[40:43], s8 offen nt
  s_add_u32 s8, s8, 8192
  s_waitcnt vmcnt(4)
  buffer_load_dwordx4 v[76:79], v120, s[40:43], s8 offen nt
  s_add_u32 s8, s8, 8192
  s_waitcnt vmcnt(4)
  buffer_load_dwordx4 v[80:83], v120, s[40:43], s8 offen nt
  s_add_u32 s8, s8, 8192
  s_waitcnt vmcnt(4)
  buffer_load_dwordx4 v[84:87], v120, s[40:43], s8 offen nt
  s_add_u32 s8, s8, s57
  s_waitcnt vmcnt(4)
  buffer_load_dwordx4 v[88:91], v120, s[40:43], s8 offen nt
  s_add_u32 s8, s8, 8192
  s_waitcnt vmcnt(4)
  buffer_load_dwordx4 v[92:95], v120, s[40:43], s8 offen nt
  s_add_u32 s8, s8, 8192
  s_waitcnt vmcnt(4)
  buffer_load_dwordx4 v[96:99], v120, s[40:43], s8 offen nt
  s_add_u32 s8, s8, 8192
  s_waitcnt vmcnt(4)
  buffer_load_dwordx4 v[100:103], v120, s[40:43], s8 offen nt
  s_add_u32 s8, s8, s57
  buffer_load_dwordx4 v[104:107], v120, s[40:43], s8 offen nt
  s_add_u32 s8, s8, 8192
  buffer_load_dwordx4 v[108:111], v120, s[40:43], s8 offen nt
  s_add_u32 s8, s8, 8192
  buffer_load_dwordx4 v[112:115], v120, s[40:43], s8 offen nt
  s_add_u32 s8, s8, 8192
  buffer_load_dwordx4 v[116:119], v120, s[40:43], s8 offen nt
L_YL3:
  s_sub_u32 s15, s2, 0
  s_mov_b32 s32, s34
  s_mov_b32 s33, s35
  s_mov_b32 s34, 0x800
  s_mov_b32 s35, 0x20000
  v_lshrrev_b32 v122, 2, v0
  v_mul_u32_u24 v122, 4224, v122
  v_and_b32 v9, 3, v0
  v_lshl_add_u32 v122, v9, 4, v122
  v_and_b32 v11, 15, v0
  v_and_b32 v10, 12, v0
  v_add_u32 v125, v11, v10
  v_lshlrev_b32 v125, 1, v125
  s_cmp_ge_u32 s15, 64
  s_cbranch_scc1 Lrs_19
  s_lshr_b32 s7, s15, 3
  s_and_b32 s5, s15, 7
  s_xor_b32 s5, s5, 4
  s_lshl_b32 s5, s5, 3
  s_add_u32 s5, s5, s7
  s_lshl_b32 s6, s4, 4
  s_mul_i32 s7, s4, 14
  s_add_u32 s7, s7, 8
  s_cmp_lt_u32 s4, 4
  s_cselect_b32 s6, s6, s7
  s_cselect_b32 s45, -1, 0x00ffffff
  s_mov_b32 s44, -1
  s_mul_i32 s6, s6, 4224
  s_mul_i32 s9, s5, 64
  s_add_u32 s9, s9, s6
  s_add_u32 s9, s9, 950272
  s_lshr_b32 s8, s5, 3
  s_lshl_b32 s8, s8, 8
  s_and_b32 s6, s5, 3
  s_lshl_b32 s6, s6, 6
  s_add_u32 s8, s8, s6
  s_and_b32 s6, s5, 4
  s_lshl_b32 s6, s6, 1
  s_add_u32 s8, s8, s6
  s_add_u32 s6, s8, 77824
  v_add_u32 v10, s6, v125
  ds_read_u16 v126, v10
  v_mov_b32 v44, 0
  v_mov_b32 v45, 0
  v_mov_b32 v46, 0
  v_mov_b32 v47, 0
  v_lshrrev_b32 v10, 4, v0
  v_lshl_add_u32 v9, v9, 2, v10
  v_mul_u32_u24 v123, 48, v9
  s_lshl_b32 s6, s4, 2
  v_add_u32 v123, s6, v123
  v_mul_u32_u24 v124, 48, v11
  v_mov_b32 v127, 0
  v_mov_b32 v43, 1
  s_mov_b32 s7, 4000001
  s_waitcnt lgkmcnt(0)
  v_lshlrev_b32 v126, 16, v126
Lrs_19:
  s_setprio 3
  v_and_b32 v9, 56, v0
  v_lshlrev_b32 v9, 2, v9
  s_barrier
  ds_read_b128 v[24:27], v9 offset:512
  ds_read_b128 v[28:31], v9 offset:528
  s_waitcnt lgkmcnt(1)
  v_and_b32 v12, v24, v4
  v_and_b32 v13, v24, v5
  v_and_b32 v14, v24, v6
  v_and_b32 v15, v24, v7
  v_and_b32 v16, v25, v4
  v_and_b32 v17, v25, v5
  s_waitcnt vmcnt(15)
  v_mfma_f32_16x16x32_bf16 v[20:23], v[12:15], v[56:59], 0
  v_and_b32 v18, v25, v6
  v_and_b32 v19, v25, v7
  s_waitcnt vmcnt(14)
  v_mfma_f32_16x16x32_bf16 v[48:51], v[12:15], v[60:63], 0
  v_and_b32 v12, v26, v4
  v_and_b32 v13, v26, v5
  s_waitcnt vmcnt(13)
  v_mfma_f32_16x16x32_bf16 v[20:23], v[16:19], v[64:67], v[20:23]
  v_and_b32 v14, v26, v6
  v_and_b32 v15, v26, v7
  s_waitcnt vmcnt(12)
  v_mfma_f32_16x16x32_bf16 v[48:51], v[16:19], v[68:71], v[48:51]
  v_and_b32 v16, v27, v4
  v_and_b32 v17, v27, v5
  s_waitcnt vmcnt(11) lgkmcnt(0)
  v_mfma_f32_16x16x32_bf16 v[20:23], v[12:15], v[72:75], v[20:23]
  v_and_b32 v18, v27, v6
  v_and_b32 v19, v27, v7
  s_waitcnt vmcnt(10)
  v_mfma_f32_16x16x32_bf16 v[48:51], v[12:15], v[76:79], v[48:51]
  v_and_b32 v12, v28, v4
  v_and_b32 v13, v28, v5
  s_waitcnt vmcnt(9)
  v_mfma_f32_16x16x32_bf16 v[20:23], v[16:19], v[80:83], v[20:23]
  v_and_b32 v14, v28, v6
  v_and_b32 v15, v28, v7
  s_waitcnt vmcnt(8)
  v_mfma_f32_16x16x32_bf16 v[48:51], v[16:19], v[84:87], v[48:51]
  v_and_b32 v16, v29, v4
  v_and_b32 v17, v29, v5
  s_waitcnt vmcnt(7)
  v_mfma_f32_16x16x32_bf16 v[20:23], v[12:15], v[88:91], v[20:23]
  v_and_b32 v18, v29, v6
  v_and_b32 v19, v29, v7
  s_waitcnt vmcnt(6)
  v_mfma_f32_16x16x32_bf16 v[48:51], v[12:15], v[92:95], v[48:51]
  v_and_b32 v12, v30, v4
  v_and_b32 v13, v30, v5
  s_waitcnt vmcnt(5)
  v_mfma_f32_16x16x32_bf16 v[20:23], v[16:19], v[96:99], v[20:23]
  v_and_b32 v14, v30, v6
  v_and_b32 v15, v30, v7
  s_waitcnt vmcnt(4)
  v_mfma_f32_16x16x32_bf16 v[48:51], v[16:19], v[100:103], v[48:51]
  v_and_b32 v16, v31, v4
  v_and_b32 v17, v31, v5
  s_waitcnt vmcnt(3)
  v_mfma_f32_16x16x32_bf16 v[20:23], v[12:15], v[104:107], v[20:23]
  v_and_b32 v18, v31, v6
  v_and_b32 v19, v31, v7
  s_waitcnt vmcnt(2)
  v_mfma_f32_16x16x32_bf16 v[48:51], v[12:15], v[108:111], v[48:51]
  s_waitcnt vmcnt(1)
  v_mfma_f32_16x16x32_bf16 v[20:23], v[16:19], v[112:115], v[20:23]
  s_waitcnt vmcnt(0)
  v_mfma_f32_16x16x32_bf16 v[48:51], v[16:19], v[116:119], v[48:51]
  s_nop 7
  v_permlane32_swap_b32 v48, v24
  v_permlane32_swap_b32 v49, v25
  v_permlane32_swap_b32 v50, v26
  v_permlane32_swap_b32 v51, v27
  s_mov_b32 exec_hi, 0
  v_pk_add_f32 v[20:21], v[20:21], v[24:25]
  v_pk_add_f32 v[22:23], v[22:23], v[26:27]
  v_add_u32 v20, 8, v20
  v_add_u32 v21, 8, v21
  v_add_u32 v22, 8, v22
  v_add_u32 v23, 8, v23
  v_bfi_b32 v20, 15, s11, v20
  v_bfi_b32 v21, 15, s12, v21
  v_bfi_b32 v22, 15, s13, v22
  v_bfi_b32 v23, 15, s14, v23
  buffer_store_dwordx4 v[20:23], v121, s[36:39], s59 offen sc1
  s_mov_b64 exec, -1
L_R:
  s_cmp_ge_u32 s15, 64
  s_cbranch_scc1 L_fin
  s_barrier
Lil_20:
  s_wqm_b64 exec, s[44:45]
  buffer_load_dwordx4 v[44:47], v122, s[36:39], s9 offen sc1
  s_sub_u32 s7, s7, 1
  s_cbranch_scc1 L_fail
  s_waitcnt vmcnt(0)
  v_xor_b32 v44, s11, v44
  v_xor_b32 v45, s12, v45
  v_xor_b32 v46, s13, v46
  v_xor_b32 v47, s14, v47
  v_or3_b32 v9, v44, v45, v46
  v_bitop3_b32 v9, v9, v47, 15 bitop3:0xa8
  v_cmp_ne_u32 s[44:45], 0, v9
  s_mov_b64 exec, -1
  s_cmp_lg_u64 s[44:45], 0
  s_cbranch_scc1 Lil_20
  v_permlane32_swap_b32 v44, v46
  v_permlane32_swap_b32 v45, v47
  s_nop 0
  v_add_f32 v44, v44, v46
  v_add_f32 v45, v45, v47
  s_nop 1
  v_permlane16_swap_b32 v44, v45
  s_nop 0
  v_add_f32 v44, v44, v45
  s_nop 1
  v_add_f32_dpp v44, v44, v44 row_ror:4 row_mask:0xf bank_mask:0xf
  s_nop 1
  v_add_f32_dpp v44, v44, v44 row_ror:8 row_mask:0xf bank_mask:0xf
  ds_write_b32 v123, v44 offset:2048
  s_mov_b64 exec, 1
  ds_add_rtn_u32 v43, v127, v43 offset:8
  s_mov_b64 exec, -1
  ds_read_b128 v[28:31], v124 offset:2064
  ds_read_b128 v[24:27], v124 offset:2048
  s_waitcnt lgkmcnt(2)
  v_readfirstlane_b32 s6, v43
  s_waitcnt lgkmcnt(1)
  s_cmp_lg_u32 s6, 7
  s_cbranch_scc1 L_fin
  v_add_f32 v28, v28, v29
  v_add_f32 v30, v30, v31
  v_add_f32 v28, v28, v30
  v_cvt_pk_bf16_f32 v28, v28, v28
  v_lshlrev_b32 v28, 16, v28
  v_mul_f32 v10, 0xbfb8aa3b, v28
  v_exp_f32 v10, v10
  s_waitcnt lgkmcnt(0)
  v_add_f32 v24, v24, v25
  v_add_f32 v10, 1.0, v10
  v_rcp_f32 v10, v10
  v_add_f32 v26, v26, v27
  v_add_f32 v24, v24, v26
  v_mul_f32 v10, v28, v10
  v_cvt_pk_bf16_f32 v10, v10, v24
  v_and_b32 v24, 0xffff0000, v10
  v_lshlrev_b32 v10, 16, v10
  v_mul_f32 v10, v24, v10
  v_cvt_pk_bf16_f32 v10, v10, v10
  v_lshlrev_b32 v10, 16, v10
  v_add_f32 v10, v126, v10
  s_mov_b64 exec, 0xffff
  v_cvt_pk_bf16_f32 v10, v10, v10
  buffer_store_short v10, v125, s[32:35], s8 offen
  s_mov_b64 exec, -1
  s_cmp_lg_u32 s5, 0
  s_cbranch_scc1 L_fin
  s_mov_b64 exec, 1
  v_mov_b32 v10, s10
  buffer_store_dword v10, off, s[36:39], 0 offset:0
  s_mov_b64 exec, -1
  s_endpgm
L_C0:
L_fin:
L_end:
  s_endpgm
Lrt_2:
  s_mov_b32 s7, 4000000
Lrl_3:
  s_wqm_b64 exec, s[16:17]
  s_cbranch_execz Lms_7
  buffer_load_dwordx4 v[24:27], v16, s[36:39], s9 offen sc1
Lms_7:
  s_wqm_b64 exec, s[18:19]
  s_cbranch_execz Lms_8
  buffer_load_dwordx4 v[28:31], v16, s[36:39], s56 offen sc1
Lms_8:
  s_wqm_b64 exec, s[20:21]
  s_cbranch_execz Lms_9
  buffer_load_dwordx4 v[32:35], v17, s[36:39], s9 offen sc1
Lms_9:
  s_wqm_b64 exec, s[22:23]
  s_cbranch_execz Lms_10
  buffer_load_dwordx4 v[36:39], v17, s[36:39], s56 offen sc1
Lms_10:
  s_sub_u32 s7, s7, 1
  s_cbranch_scc1 L_fail
  s_waitcnt vmcnt(0)
  s_wqm_b64 exec, s[16:17]
  v_xor_b32 v24, s11, v24
  v_xor_b32 v25, s12, v25
  v_xor_b32 v26, s13, v26
  v_xor_b32 v27, s14, v27
  v_or3_b32 v9, v24, v25, v26
  v_bitop3_b32 v9, v9, v27, 15 bitop3:0xa8
  v_cmp_ne_u32 s[16:17], 0, v9
  s_wqm_b64 exec, s[18:19]
  v_xor_b32 v28, s11, v28
  v_xor_b32 v29, s12, v29
  v_xor_b32 v30, s13, v30
  v_xor_b32 v31, s14, v31
  v_or3_b32 v9, v28, v29, v30
  v_bitop3_b32 v9, v9, v31, 15 bitop3:0xa8
  v_cmp_ne_u32 s[18:19], 0, v9
  s_wqm_b64 exec, s[20:21]
  v_xor_b32 v32, s11, v32
  v_xor_b32 v33, s12, v33
  v_xor_b32 v34, s13, v34
  v_xor_b32 v35, s14, v35
  v_or3_b32 v9, v32, v33, v34
  v_bitop3_b32 v9, v9, v35, 15 bitop3:0xa8
  v_cmp_ne_u32 s[20:21], 0, v9
  s_wqm_b64 exec, s[22:23]
  v_xor_b32 v36, s11, v36
  v_xor_b32 v37, s12, v37
  v_xor_b32 v38, s13, v38
  v_xor_b32 v39, s14, v39
  v_or3_b32 v9, v36, v37, v38
  v_bitop3_b32 v9, v9, v39, 15 bitop3:0xa8
  v_cmp_ne_u32 s[22:23], 0, v9
  s_or_b64 vcc, s[16:17], s[18:19]
  s_or_b64 vcc, vcc, s[20:21]
  s_or_b64 vcc, vcc, s[22:23]
  s_cbranch_scc1 Lrl_3
  s_mov_b64 exec, -1
  s_branch Lok_4
L_fail:
  s_endpgm
.section .rodata,"a"
.p2align 6
.amdhsa_kernel recurrent_scan__sliding_block_cached__glu_gated_glu__decode_kernel
  .amdhsa_next_free_vgpr 128
  .amdhsa_next_free_sgpr 64
  .amdhsa_accum_offset 128
  .amdhsa_group_segment_fixed_size 0
  .amdhsa_kernarg_size 96
  .amdhsa_user_sgpr_count 2
  .amdhsa_user_sgpr_kernarg_segment_ptr 1
  .amdhsa_system_sgpr_workgroup_id_x 1
.end_amdhsa_kernel
```
